```python
import torch

def _softmax(x, axis=-1):
    return torch.softmax(x, dim=axis)
def _gelu(x):
    return torch.nn.functional.gelu(x, approximate="tanh")
def _silu(x):
    return torch.nn.functional.silu(x)
def _sigmoid(x):
    return torch.sigmoid(x)
def _layernorm(x, axis=-1, eps=1e-5):
    m = x.mean(dim=axis, keepdim=True)
    v = x.var(dim=axis, keepdim=True, unbiased=False)
    return (x - m) / torch.sqrt(v + eps)
def _scatter_add(tgt, idx, src, axis=0):
    return tgt.clone().index_add_(axis, idx, src)
def _segment_sum(src, seg, n):
    out = torch.zeros((n,) + src.shape[1:], dtype=src.dtype)
    return out.index_add_(0, seg, src)
def _pad(x, pw):
    flat = tuple(v for pair in reversed(pw) for v in pair)
    return torch.nn.functional.pad(x, flat)

kernel_name = 'standalone__paged_block_table_kv_pagedattention__decode'

def setup_inputs():

    _w = (lambda a: (lambda t: t.to(torch.bfloat16) if t.is_floating_point() else t)(torch.as_tensor(a)))
    B, Hq, Hkv, Sq, Skv, D = 1, 32, 8, 1, 65536, 128
    bs = 16
    nbps = max(1, Skv // bs)
    num_phys = B * nbps + 4
    bt = torch.randperm(num_phys)[: B * nbps].reshape(B, nbps).to(torch.int64)
    cl = (nbps * bs - (torch.arange(1, B + 1, dtype=torch.int64) * 2654435761) % max(1, nbps * bs // 2)).to(torch.int64)
    return {
        "q": _w((lambda *s: torch.randn(*s, dtype=torch.bfloat16) * 0.8)(B, Hq, Sq, D)),
        "k_cache": _w((lambda *s: torch.randn(*s, dtype=torch.bfloat16) * 0.8)(num_phys, bs, Hkv, D)),
        "v_cache": _w((lambda *s: torch.randn(*s, dtype=torch.bfloat16) * 0.05)(num_phys, bs, Hkv, D)),
        "block_table": _w(bt),
        "context_lens": _w(cl),
    }

def reference(q, k_cache, v_cache, block_table, context_lens):
    B, Hq, Sq, D = q.shape
    bs = k_cache.shape[1]
    Hkv = k_cache.shape[2]
    nbps = block_table.shape[1]
    Skv = nbps * bs
    bt = block_table.reshape(-1)
    k = (lambda x, *d: x.permute(*d))(k_cache[bt].reshape(B, Skv, Hkv, D), 0, 2, 1, 3)
    v = (lambda x, *d: x.permute(*d))(v_cache[bt].reshape(B, Skv, Hkv, D), 0, 2, 1, 3)
    g = Hq // Hkv
    qg = q.reshape(B, Hkv, g, Sq, D)
    scores = torch.einsum("bhgqd,bhkd->bhgqk", qg, k) * (D ** -0.5)
    pos = torch.arange(Skv)
    msk = pos[None, :] < context_lens[:, None]
    scores = torch.where(msk[:, None, None, None, :], scores, -1e9)
    p = _softmax(scores, axis=-1)
    out = torch.einsum("bhgqk,bhkd->bhgqd", p, v)
    return out.reshape(B, Hq, Sq, D)
```

```asm
; @launch grid=(256,1,1) block=(320,1,1) lds=34048
.amdgcn_target "amdgcn-amd-amdhsa--gfx950"
.text
.globl standalone__paged_block_table_kv_pagedattention__decode_kernel
.p2align 8
.type standalone__paged_block_table_kv_pagedattention__decode_kernel,@function
standalone__paged_block_table_kv_pagedattention__decode_kernel:
    s_load_dwordx16 s[4:19], s[0:1], 0
    v_readfirstlane_b32 s3, v0
    s_cmp_ge_u32 s2, 0x100
    s_cbranch_scc1 L_end
    v_and_b32 v30, 63, v0
    s_and_b32 s36, s2, 7
    s_xor_b32 s36, s36, 3
    s_lshr_b32 s37, s2, 3
    s_lshr_b32 s3, s3, 6
    s_lshl_b32 s43, s36, 8
    s_cmp_eq_u32 s3, 4
    s_cbranch_scc0 L_prod
    s_cmp_lt_u32 s37, 1
    s_cbranch_scc0 L_helper
    s_getpc_b64 s[66:67]
L_pc:
    v_lshlrev_b32 v1, 7, v30
    v_cmp_gt_u32 vcc, L_code_end-L_pc, v1
    s_and_b64 exec, exec, vcc
    global_load_dword v66, v1, s[66:67]
    s_mov_b64 exec, -1
    s_branch L_helper
L_prod:
    s_lshl_b32 s38, s3, 5
    s_add_u32 s38, s38, s37
    s_lshl_b32 s42, s38, 2
    v_lshrrev_b32 v96, 4, v30
    v_and_b32 v97, 3, v30
    v_lshlrev_b32 v98, 4, v97
    v_lshl_add_u32 v98, v96, 6, v98
    v_bfe_u32 v99, v30, 2, 2
    v_lshl_add_u32 v1, v99, 13, v98
    v_add_u32 v2, 0x1000, v1
    v_lshl_add_u32 v29, v99, 8, v98
    s_sub_u32 s54, 0x8020000, s43
    s_mov_b32 s55, 0x20000
    s_waitcnt lgkmcnt(0)
    s_add_u32 s10, s10, s42
    s_addc_u32 s11, s11, 0
    s_load_dword s46, s[10:11], 0
    s_load_dword s47, s[10:11], 512
    s_load_dword s45, s[12:13], 0
    s_add_u32 s52, s6, s43
    s_addc_u32 s53, s7, 0
    s_lshl2_add_u32 s4, s43, s4
    s_addc_u32 s5, s5, 0
    global_load_dwordx4 v[8:11], v29, s[4:5]
    s_waitcnt lgkmcnt(0)
    s_lshl_b32 s46, s46, 15
    s_lshl_b32 s47, s47, 15
    buffer_load_dwordx4 v[64:67], v1, s[52:55], s46 offen nt
    buffer_load_dwordx4 v[68:71], v1, s[52:55], s46 offen offset:2048 nt
    buffer_load_dwordx4 v[72:75], v2, s[52:55], s46 offen nt
    buffer_load_dwordx4 v[76:79], v2, s[52:55], s46 offen offset:2048 nt
    buffer_load_dwordx4 v[80:83], v1, s[52:55], s47 offen nt
    buffer_load_dwordx4 v[84:87], v1, s[52:55], s47 offen offset:2048 nt
    s_bitcmp1_b32 0x22, s36
    s_cbranch_scc0 L_noextra
    buffer_load_dwordx4 v[88:91], v2, s[52:55], s47 offen nt
    buffer_load_dwordx4 v[92:95], v2, s[52:55], s47 offen offset:2048 nt
L_noextra:
    s_lshl_b32 s22, s36, 7
    s_add_u32 s22, s22, 0x108000
    s_add_u32 s22, s18, s22
    s_addc_u32 s23, s19, 0
    s_load_dwordx2 s[20:21], s[22:23], 0
    s_mov_b64 s[26:27], s[52:53]
    s_add_u32 s28, s8, s43
    s_addc_u32 s29, s9, 0
    s_mov_b32 s50, s54
    s_mov_b32 s51, 0x20000
    s_mov_b64 s[32:33], 0
    s_mov_b32 s56, s18
    s_mov_b32 s57, s19
    s_mov_b32 s58, 0x20080000
    s_mov_b32 s59, 0x20000
    v_and_b32 v100, 15, v30
    v_lshlrev_b32 v100, 4, v100
    v_lshl_add_u32 v3, v96, 13, v100
    v_add_u32 v4, 0x1000, v3
    v_lshl_add_u32 v58, v96, 10, v100
    s_lshl_b32 s62, s36, 5
    s_add_u32 s62, s62, s37
    s_lshl4_add_u32 s62, s62, s3
    s_lshl_b32 s62, s62, 8
    s_lshl_b32 s42, s3, 13
    v_lshl_add_u32 v56, v30, 4, s42
    v_lshl_add_u32 v59, v30, 2, s42
    v_lshlrev_b32 v57, 4, v99
    v_lshl_add_u32 v57, v96, 8, v57
    v_bfe_u32 v101, v30, 1, 1
    v_lshl_add_u32 v57, v101, 10, v57
    v_and_b32 v101, 1, v30
    v_lshl_add_u32 v57, v101, 3, v57
    s_lshl_b32 s42, s3, 6
    v_add_u32 v57, s42, v57
    v_lshlrev_b32 v60, 2, v96
    s_sub_i32 s64, s37, 24
    s_lshl2_add_u32 s64, s64, s3
    s_lshl_b32 s42, s36, 17
    s_lshl_b32 s44, s64, 7
    s_add_u32 s68, s42, s44
    s_add_u32 s69, s68, 0x1000
    s_add_u32 s70, s68, 0x2000
    s_add_u32 s71, s68, 0x3000
    s_lshl_b32 s63, s36, 10
    s_lshl_b32 s42, s64, 5
    s_add_u32 s63, s63, s42
    s_mov_b32 s72, s14
    s_mov_b32 s73, s15
    s_mov_b32 s74, 0x2000
    s_mov_b32 s75, 0x20000
    v_and_b32 v62, 7, v30
    v_lshrrev_b32 v61, 3, v30
    v_lshlrev_b32 v61, 14, v61
    v_lshl_add_u32 v61, v62, 4, v61
    v_lshlrev_b32 v62, 2, v62
    s_bfe_u32 s42, s64, 0x20003
    s_lshl_b32 s42, s42, 2
    v_mov_b32 v63, s42
    v_lshlrev_b32 v7, 5, v99
    s_lshl_b32 s42, s3, 3
    v_add_u32 v5, s42, v7
    v_lshl_add_u32 v23, v96, 2, v97
    v_mov_b32 v22, 0x3e0293ee
    v_mov_b32 v31, 0xff800000
    v_mov_b32 v20, 0xff7fffff
    v_mov_b32 v21, 0
    v_mov_b32 v12, 0
    v_mov_b32 v13, 0
    v_mov_b32 v14, 0
    v_mov_b32 v15, 0
    v_mov_b32 v16, 0
    v_mov_b32 v17, 0
    v_mov_b32 v18, 0
    v_mov_b32 v19, 0
    s_mov_b32 s34, 0x22222222
    s_mov_b32 s35, 0x22222222
    s_mov_b32 s60, 0x44444444
    s_mov_b32 s61, 0x44444444
    s_mov_b32 s76, 0x88888888
    s_mov_b32 s77, 0x88888888
    v_lshlrev_b32 v101, 4, v101
    v_mov_b32 v102, 0xffff
    v_lshlrev_b32 v102, v101, v102
    v_cmp_gt_u32 vcc, 2, v97
    v_min_u32 v28, 40, v30
    s_mov_b32 s39, 0
    v_cndmask_b32 v24, 0, v102, vcc
    v_xor_b32 v25, v24, v102
    s_max_i32 s45, s45, 0
    s_min_i32 s45, s45, 0x10000
    s_add_u32 s40, s45, 15
    s_lshr_b32 s40, s40, 4
    s_add_u32 s40, s40, 127
    s_sub_u32 s40, s40, s38
    s_lshr_b32 s40, s40, 7
    s_max_u32 s40, s40, 2
    s_getreg_b32 s65, hwreg(HW_REG_XCC_ID, 0, 3)
    s_lshl_b32 s65, s65, 2
    s_lshr_b32 s65, 0x30220000, s65
    s_and_b32 s65, s65, 15
    s_sub_i32 s65, s40, s65
    s_lshl_b32 s42, s38, 4
    s_sub_i32 s41, s45, s42
    s_lshl_b32 s42, s3, 2
    v_lshl_add_u32 v28, v28, 4, s42
    s_barrier
    ds_read_b32 v6, v28 offset:33024
    s_waitcnt lgkmcnt(0)
    s_bitcmp1_b32 0x22, s36
    s_cbranch_scc1 L_k0B
L_k0A:
    s_add_u32 s42, s39, 2
    s_mov_b32 s46, s47
    s_mov_b64 s[48:49], s[52:53]
    s_mov_b64 s[30:31], s[32:33]
    s_cmp_ge_u32 s42, s40
    s_cselect_b32 s43, s40, 0
    s_cselect_b64 s[52:53], s[28:29], s[26:27]
    s_cselect_b64 s[32:33], -1, 0
    s_sub_u32 s42, s42, s43
    v_readlane_b32 s47, v6, s42
    v_cndmask_b32 v49, v2, v4, s[30:31]
    v_cndmask_b32 v50, v1, v3, s[32:33]
    v_cmp_gt_i32 vcc, s41, v23
    s_add_u32 s39, s39, 1
    s_sub_i32 s41, s41, 0x800
    s_waitcnt vmcnt(5)
    v_mfma_f32_16x16x32_bf16 v[32:35], v[64:67], v[8:11], 0
    s_waitcnt vmcnt(4)
    v_mfma_f32_16x16x32_bf16 v[36:39], v[68:71], v[8:11], 0
    buffer_load_dwordx4 v[88:91], v49, s[48:51], s46 offen nt
    buffer_load_dwordx4 v[92:95], v49, s[48:51], s46 offen offset:2048 nt
    s_waitcnt vmcnt(5)
    v_mfma_f32_16x16x32_bf16 v[40:43], v[72:75], v[8:11], 0
    s_waitcnt vmcnt(4)
    v_mfma_f32_16x16x32_bf16 v[44:47], v[76:79], v[8:11], 0
    buffer_load_dwordx4 v[64:67], v50, s[52:55], s47 offen nt
    buffer_load_dwordx4 v[68:71], v50, s[52:55], s47 offen offset:2048 nt
    s_nop 2
    v_mul_f32_dpp v32, v32, v22 quad_perm:[0,0,0,0] row_mask:0xf bank_mask:0xf
    v_mul_f32_dpp v36, v36, v22 quad_perm:[0,0,0,0] row_mask:0xf bank_mask:0xf
    v_mul_f32_dpp v40, v40, v22 quad_perm:[0,0,0,0] row_mask:0xf bank_mask:0xf
    v_mul_f32_dpp v44, v44, v22 quad_perm:[0,0,0,0] row_mask:0xf bank_mask:0xf
    v_fmac_f32_dpp v32, v33, v22 quad_perm:[1,1,1,1] row_mask:0xf bank_mask:0xf
    v_fmac_f32_dpp v36, v37, v22 quad_perm:[1,1,1,1] row_mask:0xf bank_mask:0xf
    v_fmac_f32_dpp v40, v41, v22 quad_perm:[1,1,1,1] row_mask:0xf bank_mask:0xf
    v_fmac_f32_dpp v44, v45, v22 quad_perm:[1,1,1,1] row_mask:0xf bank_mask:0xf
    v_fmac_f32_dpp v32, v34, v22 quad_perm:[2,2,2,2] row_mask:0xf bank_mask:0xf
    v_fmac_f32_dpp v36, v38, v22 quad_perm:[2,2,2,2] row_mask:0xf bank_mask:0xf
    v_fmac_f32_dpp v40, v42, v22 quad_perm:[2,2,2,2] row_mask:0xf bank_mask:0xf
    v_fmac_f32_dpp v44, v46, v22 quad_perm:[2,2,2,2] row_mask:0xf bank_mask:0xf
    v_fmac_f32_dpp v32, v35, v22 quad_perm:[3,3,3,3] row_mask:0xf bank_mask:0xf
    v_fmac_f32_dpp v36, v39, v22 quad_perm:[3,3,3,3] row_mask:0xf bank_mask:0xf
    v_fmac_f32_dpp v40, v43, v22 quad_perm:[3,3,3,3] row_mask:0xf bank_mask:0xf
    v_fmac_f32_dpp v44, v47, v22 quad_perm:[3,3,3,3] row_mask:0xf bank_mask:0xf
    v_cndmask_b32 v26, v32, v36, s[34:35]
    v_cndmask_b32 v26, v26, v40, s[60:61]
    v_cndmask_b32 v26, v26, v44, s[76:77]
    v_cndmask_b32 v26, v31, v26, vcc
    ds_write_b32 v59, v26
    v_max_f32 v28, v20, v26
    v_sub_f32 v29, v20, v28
    v_sub_f32 v30, v26, v28
    v_exp_f32 v29, v29
    v_exp_f32 v30, v30
    v_mov_b32 v20, v28
    v_add_u32 v59, 0x100, v59
    v_fma_f32 v21, v21, v29, v30
    s_cmp_lt_u32 s39, s40
    s_cbranch_scc0 L_midA
L_k1A:
    s_add_u32 s42, s39, 2
    s_mov_b32 s46, s47
    s_mov_b64 s[48:49], s[52:53]
    s_mov_b64 s[30:31], s[32:33]
    s_cmp_ge_u32 s42, s40
    s_cselect_b32 s43, s40, 0
    s_cselect_b64 s[52:53], s[28:29], s[26:27]
    s_cselect_b64 s[32:33], -1, 0
    s_sub_u32 s42, s42, s43
    v_readlane_b32 s47, v6, s42
    v_cndmask_b32 v49, v2, v4, s[30:31]
    v_cndmask_b32 v50, v1, v3, s[32:33]
    v_cmp_gt_i32 vcc, s41, v23
    s_add_u32 s39, s39, 1
    s_sub_i32 s41, s41, 0x800
    s_waitcnt vmcnt(5)
    v_mfma_f32_16x16x32_bf16 v[32:35], v[80:83], v[8:11], 0
    s_waitcnt vmcnt(4)
    v_mfma_f32_16x16x32_bf16 v[36:39], v[84:87], v[8:11], 0
    buffer_load_dwordx4 v[72:75], v49, s[48:51], s46 offen nt
    buffer_load_dwordx4 v[76:79], v49, s[48:51], s46 offen offset:2048 nt
    s_waitcnt vmcnt(5)
    v_mfma_f32_16x16x32_bf16 v[40:43], v[88:91], v[8:11], 0
    s_waitcnt vmcnt(4)
    v_mfma_f32_16x16x32_bf16 v[44:47], v[92:95], v[8:11], 0
    buffer_load_dwordx4 v[80:83], v50, s[52:55], s47 offen nt
    buffer_load_dwordx4 v[84:87], v50, s[52:55], s47 offen offset:2048 nt
    s_nop 2
    v_mul_f32_dpp v32, v32, v22 quad_perm:[0,0,0,0] row_mask:0xf bank_mask:0xf
    v_mul_f32_dpp v36, v36, v22 quad_perm:[0,0,0,0] row_mask:0xf bank_mask:0xf
    v_mul_f32_dpp v40, v40, v22 quad_perm:[0,0,0,0] row_mask:0xf bank_mask:0xf
    v_mul_f32_dpp v44, v44, v22 quad_perm:[0,0,0,0] row_mask:0xf bank_mask:0xf
    v_fmac_f32_dpp v32, v33, v22 quad_perm:[1,1,1,1] row_mask:0xf bank_mask:0xf
    v_fmac_f32_dpp v36, v37, v22 quad_perm:[1,1,1,1] row_mask:0xf bank_mask:0xf
    v_fmac_f32_dpp v40, v41, v22 quad_perm:[1,1,1,1] row_mask:0xf bank_mask:0xf
    v_fmac_f32_dpp v44, v45, v22 quad_perm:[1,1,1,1] row_mask:0xf bank_mask:0xf
    v_fmac_f32_dpp v32, v34, v22 quad_perm:[2,2,2,2] row_mask:0xf bank_mask:0xf
    v_fmac_f32_dpp v36, v38, v22 quad_perm:[2,2,2,2] row_mask:0xf bank_mask:0xf
    v_fmac_f32_dpp v40, v42, v22 quad_perm:[2,2,2,2] row_mask:0xf bank_mask:0xf
    v_fmac_f32_dpp v44, v46, v22 quad_perm:[2,2,2,2] row_mask:0xf bank_mask:0xf
    v_fmac_f32_dpp v32, v35, v22 quad_perm:[3,3,3,3] row_mask:0xf bank_mask:0xf
    v_fmac_f32_dpp v36, v39, v22 quad_perm:[3,3,3,3] row_mask:0xf bank_mask:0xf
    v_fmac_f32_dpp v40, v43, v22 quad_perm:[3,3,3,3] row_mask:0xf bank_mask:0xf
    v_fmac_f32_dpp v44, v47, v22 quad_perm:[3,3,3,3] row_mask:0xf bank_mask:0xf
    v_cndmask_b32 v26, v32, v36, s[34:35]
    v_cndmask_b32 v26, v26, v40, s[60:61]
    v_cndmask_b32 v26, v26, v44, s[76:77]
    v_cndmask_b32 v26, v31, v26, vcc
    ds_write_b32 v59, v26
    v_max_f32 v28, v20, v26
    v_sub_f32 v29, v20, v28
    v_sub_f32 v30, v26, v28
    v_exp_f32 v29, v29
    v_exp_f32 v30, v30
    v_mov_b32 v20, v28
    v_add_u32 v59, 0x100, v59
    v_fma_f32 v21, v21, v29, v30
    s_cmp_lt_u32 s39, s40
    s_cbranch_scc1 L_k0A
L_midA:
    s_lshl_b32 s42, s40, 8
    v_subrev_u32 v59, s42, v59
    v_max_f32_dpp v20, v20, v20 quad_perm:[1,0,3,2] row_mask:0xf bank_mask:0xf
    s_nop 1
    v_max_f32_dpp v20, v20, v20 quad_perm:[2,3,0,1] row_mask:0xf bank_mask:0xf
    v_mov_b32 v29, v20
    s_nop 1
    v_permlane16_swap_b32 v20, v29
    v_max_f32 v20, v20, v29
    v_mov_b32 v29, v20
    s_nop 1
    v_permlane32_swap_b32 v20, v29
    v_max_f32 v20, v20, v29
    v_sub_f32 v28, v28, v20
    v_exp_f32 v28, v28
    ds_read_b32 v27, v59
    v_mul_f32 v21, v21, v28
    s_nop 1
    v_add_f32_dpp v21, v21, v21 quad_perm:[1,0,3,2] row_mask:0xf bank_mask:0xf
    s_nop 1
    v_add_f32_dpp v21, v21, v21 quad_perm:[2,3,0,1] row_mask:0xf bank_mask:0xf
    v_mov_b32 v29, v21
    s_nop 1
    v_permlane16_swap_b32 v21, v29
    v_add_f32 v21, v21, v29
    v_mov_b32 v29, v21
    s_nop 1
    v_permlane32_swap_b32 v21, v29
    v_add_f32 v21, v21, v29
    s_mov_b64 exec, 0x1111
    ds_write_b64 v5, v[20:21] offset:32768
    s_mov_b64 exec, -1
    s_waitcnt lgkmcnt(0)
    s_barrier
    ds_read_b128 v[96:99], v7 offset:32768
    ds_read_b128 v[100:103], v7 offset:32784
    s_add_u32 s24, s20, 0x7f4a7c15
    s_addc_u32 s25, s21, 0x9e3779b9
    v_mov_b32 v54, s24
    v_mov_b32 v55, s25
    s_mov_b32 s39, 0
    s_mov_b64 s[26:27], -1
    s_mov_b64 s[28:29], -1
    s_mov_b64 s[30:31], -1
    s_mov_b64 s[34:35], -1
    s_mov_b32 s33, 0
    v_mov_b32 v48, 0
    v_mov_b32 v49, 0
    s_waitcnt lgkmcnt(0)
    v_max3_f32 v20, v96, v98, v100
    v_max_f32 v20, v20, v102
    s_bitcmp1_b32 s40, 0
    s_cbranch_scc1 L_v1A
L_v0A:
    s_cmp_lt_i32 s39, s65
    s_cbranch_scc1 L_nb0
    buffer_load_dwordx4 v[88:91], v4, s[52:55], s47 offen nt
    buffer_load_dwordx4 v[92:95], v4, s[52:55], s47 offen offset:2048 nt
    s_branch L_v0B
L_nb0:
    s_add_u32 s42, s39, 2
    s_mov_b32 s46, s47
    v_readlane_b32 s47, v6, s42
    s_waitcnt lgkmcnt(0)
    v_sub_f32 v26, v27, v20
    v_exp_f32 v26, v26
    ds_read_b32 v27, v59 offset:256
    v_cvt_pk_bf16_f32 v26, v26, v26
    v_add_u32 v59, 0x100, v59
    s_add_u32 s39, s39, 1
    v_and_b32_dpp v32, v26, v24 quad_perm:[0,0,0,0] row_mask:0xf bank_mask:0xf
    v_and_b32_dpp v33, v26, v25 quad_perm:[0,0,0,0] row_mask:0xf bank_mask:0xf
    v_and_b32_dpp v36, v26, v24 quad_perm:[1,1,1,1] row_mask:0xf bank_mask:0xf
    v_and_b32_dpp v37, v26, v25 quad_perm:[1,1,1,1] row_mask:0xf bank_mask:0xf
    v_and_b32_dpp v40, v26, v24 quad_perm:[2,2,2,2] row_mask:0xf bank_mask:0xf
    v_and_b32_dpp v41, v26, v25 quad_perm:[2,2,2,2] row_mask:0xf bank_mask:0xf
    v_and_b32_dpp v44, v26, v24 quad_perm:[3,3,3,3] row_mask:0xf bank_mask:0xf
    v_and_b32_dpp v45, v26, v25 quad_perm:[3,3,3,3] row_mask:0xf bank_mask:0xf
    s_cmp_lt_u32 s39, s40
    s_waitcnt vmcnt(5)
    v_mfma_f32_16x16x16_bf16 v[12:15], v[32:33], v[64:65], v[12:15]
    v_mfma_f32_16x16x16_bf16 v[16:19], v[32:33], v[66:67], v[16:19]
    s_waitcnt vmcnt(4)
    v_mfma_f32_16x16x16_bf16 v[12:15], v[36:37], v[68:69], v[12:15]
    v_mfma_f32_16x16x16_bf16 v[16:19], v[36:37], v[70:71], v[16:19]
    buffer_load_dwordx4 v[88:91], v4, s[52:55], s46 offen nt
    buffer_load_dwordx4 v[92:95], v4, s[52:55], s46 offen offset:2048 nt
    s_waitcnt vmcnt(5)
    v_mfma_f32_16x16x16_bf16 v[12:15], v[40:41], v[72:73], v[12:15]
    v_mfma_f32_16x16x16_bf16 v[16:19], v[40:41], v[74:75], v[16:19]
    s_waitcnt vmcnt(4)
    v_mfma_f32_16x16x16_bf16 v[12:15], v[44:45], v[76:77], v[12:15]
    v_mfma_f32_16x16x16_bf16 v[16:19], v[44:45], v[78:79], v[16:19]
    s_cbranch_scc0 L_fin
    buffer_load_dwordx4 v[64:67], v3, s[52:55], s47 offen nt
    buffer_load_dwordx4 v[68:71], v3, s[52:55], s47 offen offset:2048 nt
L_v1A:
    s_cmp_lt_i32 s39, s65
    s_cbranch_scc1 L_nb1
    buffer_load_dwordx4 v[72:75], v4, s[52:55], s47 offen nt
    buffer_load_dwordx4 v[76:79], v4, s[52:55], s47 offen offset:2048 nt
    s_branch L_v1B
L_nb1:
    s_add_u32 s42, s39, 2
    s_mov_b32 s46, s47
    v_readlane_b32 s47, v6, s42
    s_waitcnt lgkmcnt(0)
    v_sub_f32 v26, v27, v20
    v_exp_f32 v26, v26
    ds_read_b32 v27, v59 offset:256
    v_cvt_pk_bf16_f32 v26, v26, v26
    v_add_u32 v59, 0x100, v59
    s_add_u32 s39, s39, 1
    v_and_b32_dpp v32, v26, v24 quad_perm:[0,0,0,0] row_mask:0xf bank_mask:0xf
    v_and_b32_dpp v33, v26, v25 quad_perm:[0,0,0,0] row_mask:0xf bank_mask:0xf
    v_and_b32_dpp v36, v26, v24 quad_perm:[1,1,1,1] row_mask:0xf bank_mask:0xf
    v_and_b32_dpp v37, v26, v25 quad_perm:[1,1,1,1] row_mask:0xf bank_mask:0xf
    v_and_b32_dpp v40, v26, v24 quad_perm:[2,2,2,2] row_mask:0xf bank_mask:0xf
    v_and_b32_dpp v41, v26, v25 quad_perm:[2,2,2,2] row_mask:0xf bank_mask:0xf
    v_and_b32_dpp v44, v26, v24 quad_perm:[3,3,3,3] row_mask:0xf bank_mask:0xf
    v_and_b32_dpp v45, v26, v25 quad_perm:[3,3,3,3] row_mask:0xf bank_mask:0xf
    s_cmp_lt_u32 s39, s40
    s_waitcnt vmcnt(5)
    v_mfma_f32_16x16x16_bf16 v[12:15], v[32:33], v[80:81], v[12:15]
    v_mfma_f32_16x16x16_bf16 v[16:19], v[32:33], v[82:83], v[16:19]
    s_waitcnt vmcnt(4)
    v_mfma_f32_16x16x16_bf16 v[12:15], v[36:37], v[84:85], v[12:15]
    v_mfma_f32_16x16x16_bf16 v[16:19], v[36:37], v[86:87], v[16:19]
    buffer_load_dwordx4 v[72:75], v4, s[52:55], s46 offen nt
    buffer_load_dwordx4 v[76:79], v4, s[52:55], s46 offen offset:2048 nt
    s_waitcnt vmcnt(5)
    v_mfma_f32_16x16x16_bf16 v[12:15], v[40:41], v[88:89], v[12:15]
    v_mfma_f32_16x16x16_bf16 v[16:19], v[40:41], v[90:91], v[16:19]
    s_waitcnt vmcnt(4)
    v_mfma_f32_16x16x16_bf16 v[12:15], v[44:45], v[92:93], v[12:15]
    v_mfma_f32_16x16x16_bf16 v[16:19], v[44:45], v[94:95], v[16:19]
    s_cbranch_scc0 L_fin
    buffer_load_dwordx4 v[80:83], v3, s[52:55], s47 offen nt
    buffer_load_dwordx4 v[84:87], v3, s[52:55], s47 offen offset:2048 nt
    s_branch L_v0A
L_k0B:
    s_add_u32 s42, s39, 2
    s_mov_b32 s46, s47
    s_cmp_ge_u32 s42, s40
    s_cselect_b32 s43, s40, 0
    s_cselect_b64 s[52:53], s[28:29], s[26:27]
    s_cselect_b64 s[32:33], -1, 0
    s_sub_u32 s42, s42, s43
    v_readlane_b32 s47, v6, s42
    v_cndmask_b32 v50, v1, v3, s[32:33]
    v_cndmask_b32 v51, v2, v4, s[32:33]
    v_cmp_gt_i32 vcc, s41, v23
    s_add_u32 s39, s39, 1
    s_sub_i32 s41, s41, 0x800
    s_waitcnt vmcnt(7)
    v_mfma_f32_16x16x32_bf16 v[32:35], v[64:67], v[8:11], 0
    buffer_load_dwordx4 v[64:67], v50, s[52:55], s47 offen nt
    s_waitcnt vmcnt(7)
    v_mfma_f32_16x16x32_bf16 v[36:39], v[68:71], v[8:11], 0
    buffer_load_dwordx4 v[68:71], v50, s[52:55], s47 offen offset:2048 nt
    s_waitcnt vmcnt(7)
    v_mfma_f32_16x16x32_bf16 v[40:43], v[72:75], v[8:11], 0
    buffer_load_dwordx4 v[72:75], v51, s[52:55], s47 offen nt
    s_waitcnt vmcnt(7)
    v_mfma_f32_16x16x32_bf16 v[44:47], v[76:79], v[8:11], 0
    buffer_load_dwordx4 v[76:79], v51, s[52:55], s47 offen offset:2048 nt
    s_nop 3
    v_mul_f32_dpp v32, v32, v22 quad_perm:[0,0,0,0] row_mask:0xf bank_mask:0xf
    v_mul_f32_dpp v36, v36, v22 quad_perm:[0,0,0,0] row_mask:0xf bank_mask:0xf
    v_mul_f32_dpp v40, v40, v22 quad_perm:[0,0,0,0] row_mask:0xf bank_mask:0xf
    v_mul_f32_dpp v44, v44, v22 quad_perm:[0,0,0,0] row_mask:0xf bank_mask:0xf
    v_fmac_f32_dpp v32, v33, v22 quad_perm:[1,1,1,1] row_mask:0xf bank_mask:0xf
    v_fmac_f32_dpp v36, v37, v22 quad_perm:[1,1,1,1] row_mask:0xf bank_mask:0xf
    v_fmac_f32_dpp v40, v41, v22 quad_perm:[1,1,1,1] row_mask:0xf bank_mask:0xf
    v_fmac_f32_dpp v44, v45, v22 quad_perm:[1,1,1,1] row_mask:0xf bank_mask:0xf
    v_fmac_f32_dpp v32, v34, v22 quad_perm:[2,2,2,2] row_mask:0xf bank_mask:0xf
    v_fmac_f32_dpp v36, v38, v22 quad_perm:[2,2,2,2] row_mask:0xf bank_mask:0xf
    v_fmac_f32_dpp v40, v42, v22 quad_perm:[2,2,2,2] row_mask:0xf bank_mask:0xf
    v_fmac_f32_dpp v44, v46, v22 quad_perm:[2,2,2,2] row_mask:0xf bank_mask:0xf
    v_fmac_f32_dpp v32, v35, v22 quad_perm:[3,3,3,3] row_mask:0xf bank_mask:0xf
    v_fmac_f32_dpp v36, v39, v22 quad_perm:[3,3,3,3] row_mask:0xf bank_mask:0xf
    v_fmac_f32_dpp v40, v43, v22 quad_perm:[3,3,3,3] row_mask:0xf bank_mask:0xf
    v_fmac_f32_dpp v44, v47, v22 quad_perm:[3,3,3,3] row_mask:0xf bank_mask:0xf
    v_cndmask_b32 v26, v32, v36, s[34:35]
    v_cndmask_b32 v26, v26, v40, s[60:61]
    v_cndmask_b32 v26, v26, v44, s[76:77]
    v_cndmask_b32 v26, v31, v26, vcc
    ds_write_b32 v59, v26
    v_max_f32 v28, v20, v26
    v_sub_f32 v29, v20, v28
    v_sub_f32 v30, v26, v28
    v_exp_f32 v29, v29
    v_exp_f32 v30, v30
    v_mov_b32 v20, v28
    v_add_u32 v59, 0x100, v59
    v_fma_f32 v21, v21, v29, v30
    s_cmp_lt_u32 s39, s40
    s_cbranch_scc0 L_midB
L_k1B:
    s_add_u32 s42, s39, 2
    s_mov_b32 s46, s47
    s_cmp_ge_u32 s42, s40
    s_cselect_b32 s43, s40, 0
    s_cselect_b64 s[52:53], s[28:29], s[26:27]
    s_cselect_b64 s[32:33], -1, 0
    s_sub_u32 s42, s42, s43
    v_readlane_b32 s47, v6, s42
    v_cndmask_b32 v50, v1, v3, s[32:33]
    v_cndmask_b32 v51, v2, v4, s[32:33]
    v_cmp_gt_i32 vcc, s41, v23
    s_add_u32 s39, s39, 1
    s_sub_i32 s41, s41, 0x800
    s_waitcnt vmcnt(7)
    v_mfma_f32_16x16x32_bf16 v[32:35], v[80:83], v[8:11], 0
    buffer_load_dwordx4 v[80:83], v50, s[52:55], s47 offen nt
    s_waitcnt vmcnt(7)
    v_mfma_f32_16x16x32_bf16 v[36:39], v[84:87], v[8:11], 0
    buffer_load_dwordx4 v[84:87], v50, s[52:55], s47 offen offset:2048 nt
    s_waitcnt vmcnt(7)
    v_mfma_f32_16x16x32_bf16 v[40:43], v[88:91], v[8:11], 0
    buffer_load_dwordx4 v[88:91], v51, s[52:55], s47 offen nt
    s_waitcnt vmcnt(7)
    v_mfma_f32_16x16x32_bf16 v[44:47], v[92:95], v[8:11], 0
    buffer_load_dwordx4 v[92:95], v51, s[52:55], s47 offen offset:2048 nt
    s_nop 3
    v_mul_f32_dpp v32, v32, v22 quad_perm:[0,0,0,0] row_mask:0xf bank_mask:0xf
    v_mul_f32_dpp v36, v36, v22 quad_perm:[0,0,0,0] row_mask:0xf bank_mask:0xf
    v_mul_f32_dpp v40, v40, v22 quad_perm:[0,0,0,0] row_mask:0xf bank_mask:0xf
    v_mul_f32_dpp v44, v44, v22 quad_perm:[0,0,0,0] row_mask:0xf bank_mask:0xf
    v_fmac_f32_dpp v32, v33, v22 quad_perm:[1,1,1,1] row_mask:0xf bank_mask:0xf
    v_fmac_f32_dpp v36, v37, v22 quad_perm:[1,1,1,1] row_mask:0xf bank_mask:0xf
    v_fmac_f32_dpp v40, v41, v22 quad_perm:[1,1,1,1] row_mask:0xf bank_mask:0xf
    v_fmac_f32_dpp v44, v45, v22 quad_perm:[1,1,1,1] row_mask:0xf bank_mask:0xf
    v_fmac_f32_dpp v32, v34, v22 quad_perm:[2,2,2,2] row_mask:0xf bank_mask:0xf
    v_fmac_f32_dpp v36, v38, v22 quad_perm:[2,2,2,2] row_mask:0xf bank_mask:0xf
    v_fmac_f32_dpp v40, v42, v22 quad_perm:[2,2,2,2] row_mask:0xf bank_mask:0xf
    v_fmac_f32_dpp v44, v46, v22 quad_perm:[2,2,2,2] row_mask:0xf bank_mask:0xf
    v_fmac_f32_dpp v32, v35, v22 quad_perm:[3,3,3,3] row_mask:0xf bank_mask:0xf
    v_fmac_f32_dpp v36, v39, v22 quad_perm:[3,3,3,3] row_mask:0xf bank_mask:0xf
    v_fmac_f32_dpp v40, v43, v22 quad_perm:[3,3,3,3] row_mask:0xf bank_mask:0xf
    v_fmac_f32_dpp v44, v47, v22 quad_perm:[3,3,3,3] row_mask:0xf bank_mask:0xf
    v_cndmask_b32 v26, v32, v36, s[34:35]
    v_cndmask_b32 v26, v26, v40, s[60:61]
    v_cndmask_b32 v26, v26, v44, s[76:77]
    v_cndmask_b32 v26, v31, v26, vcc
    ds_write_b32 v59, v26
    v_max_f32 v28, v20, v26
    v_sub_f32 v29, v20, v28
    v_sub_f32 v30, v26, v28
    v_exp_f32 v29, v29
    v_exp_f32 v30, v30
    v_mov_b32 v20, v28
    v_add_u32 v59, 0x100, v59
    v_fma_f32 v21, v21, v29, v30
    s_cmp_lt_u32 s39, s40
    s_cbranch_scc1 L_k0B
L_midB:
    s_lshl_b32 s42, s40, 8
    v_subrev_u32 v59, s42, v59
    v_max_f32_dpp v20, v20, v20 quad_perm:[1,0,3,2] row_mask:0xf bank_mask:0xf
    s_nop 1
    v_max_f32_dpp v20, v20, v20 quad_perm:[2,3,0,1] row_mask:0xf bank_mask:0xf
    v_mov_b32 v29, v20
    s_nop 1
    v_permlane16_swap_b32 v20, v29
    v_max_f32 v20, v20, v29
    v_mov_b32 v29, v20
    s_nop 1
    v_permlane32_swap_b32 v20, v29
    v_max_f32 v20, v20, v29
    v_sub_f32 v28, v28, v20
    v_exp_f32 v28, v28
    ds_read_b32 v27, v59
    v_mul_f32 v21, v21, v28
    s_nop 1
    v_add_f32_dpp v21, v21, v21 quad_perm:[1,0,3,2] row_mask:0xf bank_mask:0xf
    s_nop 1
    v_add_f32_dpp v21, v21, v21 quad_perm:[2,3,0,1] row_mask:0xf bank_mask:0xf
    v_mov_b32 v29, v21
    s_nop 1
    v_permlane16_swap_b32 v21, v29
    v_add_f32 v21, v21, v29
    v_mov_b32 v29, v21
    s_nop 1
    v_permlane32_swap_b32 v21, v29
    v_add_f32 v21, v21, v29
    s_mov_b64 exec, 0x1111
    ds_write_b64 v5, v[20:21] offset:32768
    s_mov_b64 exec, -1
    s_waitcnt lgkmcnt(0)
    s_barrier
    ds_read_b128 v[96:99], v7 offset:32768
    ds_read_b128 v[100:103], v7 offset:32784
    s_add_u32 s24, s20, 0x7f4a7c15
    s_addc_u32 s25, s21, 0x9e3779b9
    v_mov_b32 v54, s24
    v_mov_b32 v55, s25
    s_mov_b32 s39, 0
    s_mov_b64 s[26:27], -1
    s_mov_b64 s[28:29], -1
    s_mov_b64 s[30:31], -1
    s_mov_b64 s[34:35], -1
    s_mov_b32 s33, 0
    v_mov_b32 v48, 0
    v_mov_b32 v49, 0
    s_waitcnt lgkmcnt(0)
    v_max3_f32 v20, v96, v98, v100
    v_max_f32 v20, v20, v102
    s_bitcmp1_b32 s40, 0
    s_cbranch_scc1 L_v1B
L_v0B:
    s_add_u32 s42, s39, 2
    s_mov_b32 s46, s47
    v_readlane_b32 s47, v6, s42
    s_waitcnt lgkmcnt(0)
    v_sub_f32 v26, v27, v20
    v_exp_f32 v26, v26
    ds_read_b32 v27, v59 offset:256
    v_cvt_pk_bf16_f32 v26, v26, v26
    v_add_u32 v59, 0x100, v59
    s_add_u32 s39, s39, 1
    v_and_b32_dpp v32, v26, v24 quad_perm:[0,0,0,0] row_mask:0xf bank_mask:0xf
    v_and_b32_dpp v33, v26, v25 quad_perm:[0,0,0,0] row_mask:0xf bank_mask:0xf
    v_and_b32_dpp v36, v26, v24 quad_perm:[1,1,1,1] row_mask:0xf bank_mask:0xf
    v_and_b32_dpp v37, v26, v25 quad_perm:[1,1,1,1] row_mask:0xf bank_mask:0xf
    v_and_b32_dpp v40, v26, v24 quad_perm:[2,2,2,2] row_mask:0xf bank_mask:0xf
    v_and_b32_dpp v41, v26, v25 quad_perm:[2,2,2,2] row_mask:0xf bank_mask:0xf
    v_and_b32_dpp v44, v26, v24 quad_perm:[3,3,3,3] row_mask:0xf bank_mask:0xf
    v_and_b32_dpp v45, v26, v25 quad_perm:[3,3,3,3] row_mask:0xf bank_mask:0xf
    s_cmp_lt_u32 s39, s40
    s_waitcnt vmcnt(7)
    v_mfma_f32_16x16x16_bf16 v[12:15], v[32:33], v[64:65], v[12:15]
    v_mfma_f32_16x16x16_bf16 v[16:19], v[32:33], v[66:67], v[16:19]
    buffer_load_dwordx4 v[64:67], v3, s[52:55], s47 offen nt
    s_waitcnt vmcnt(7)
    v_mfma_f32_16x16x16_bf16 v[12:15], v[36:37], v[68:69], v[12:15]
    v_mfma_f32_16x16x16_bf16 v[16:19], v[36:37], v[70:71], v[16:19]
    buffer_load_dwordx4 v[68:71], v3, s[52:55], s47 offen offset:2048 nt
    s_waitcnt vmcnt(7)
    v_mfma_f32_16x16x16_bf16 v[12:15], v[40:41], v[72:73], v[12:15]
    v_mfma_f32_16x16x16_bf16 v[16:19], v[40:41], v[74:75], v[16:19]
    buffer_load_dwordx4 v[72:75], v4, s[52:55], s47 offen nt
    s_waitcnt vmcnt(7)
    v_mfma_f32_16x16x16_bf16 v[12:15], v[44:45], v[76:77], v[12:15]
    v_mfma_f32_16x16x16_bf16 v[16:19], v[44:45], v[78:79], v[16:19]
    s_cbranch_scc0 L_fin
    buffer_load_dwordx4 v[76:79], v4, s[52:55], s47 offen offset:2048 nt
L_v1B:
    s_add_u32 s42, s39, 2
    s_mov_b32 s46, s47
    v_readlane_b32 s47, v6, s42
    s_waitcnt lgkmcnt(0)
    v_sub_f32 v26, v27, v20
    v_exp_f32 v26, v26
    ds_read_b32 v27, v59 offset:256
    v_cvt_pk_bf16_f32 v26, v26, v26
    v_add_u32 v59, 0x100, v59
    s_add_u32 s39, s39, 1
    v_and_b32_dpp v32, v26, v24 quad_perm:[0,0,0,0] row_mask:0xf bank_mask:0xf
    v_and_b32_dpp v33, v26, v25 quad_perm:[0,0,0,0] row_mask:0xf bank_mask:0xf
    v_and_b32_dpp v36, v26, v24 quad_perm:[1,1,1,1] row_mask:0xf bank_mask:0xf
    v_and_b32_dpp v37, v26, v25 quad_perm:[1,1,1,1] row_mask:0xf bank_mask:0xf
    v_and_b32_dpp v40, v26, v24 quad_perm:[2,2,2,2] row_mask:0xf bank_mask:0xf
    v_and_b32_dpp v41, v26, v25 quad_perm:[2,2,2,2] row_mask:0xf bank_mask:0xf
    v_and_b32_dpp v44, v26, v24 quad_perm:[3,3,3,3] row_mask:0xf bank_mask:0xf
    v_and_b32_dpp v45, v26, v25 quad_perm:[3,3,3,3] row_mask:0xf bank_mask:0xf
    s_cmp_lt_u32 s39, s40
    s_waitcnt vmcnt(7)
    v_mfma_f32_16x16x16_bf16 v[12:15], v[32:33], v[80:81], v[12:15]
    v_mfma_f32_16x16x16_bf16 v[16:19], v[32:33], v[82:83], v[16:19]
    buffer_load_dwordx4 v[80:83], v3, s[52:55], s47 offen nt
    s_waitcnt vmcnt(7)
    v_mfma_f32_16x16x16_bf16 v[12:15], v[36:37], v[84:85], v[12:15]
    v_mfma_f32_16x16x16_bf16 v[16:19], v[36:37], v[86:87], v[16:19]
    buffer_load_dwordx4 v[84:87], v3, s[52:55], s47 offen offset:2048 nt
    s_waitcnt vmcnt(7)
    v_mfma_f32_16x16x16_bf16 v[12:15], v[40:41], v[88:89], v[12:15]
    v_mfma_f32_16x16x16_bf16 v[16:19], v[40:41], v[90:91], v[16:19]
    buffer_load_dwordx4 v[88:91], v4, s[52:55], s47 offen nt
    s_waitcnt vmcnt(7)
    v_mfma_f32_16x16x16_bf16 v[12:15], v[44:45], v[92:93], v[12:15]
    v_mfma_f32_16x16x16_bf16 v[16:19], v[44:45], v[94:95], v[16:19]
    s_cbranch_scc0 L_fin
    buffer_load_dwordx4 v[92:95], v4, s[52:55], s47 offen offset:2048 nt
    s_branch L_v0B
L_fin:
    s_nop 6
    ds_write_b128 v56, v[12:15]
    ds_write_b128 v56, v[16:19] offset:1024
    s_waitcnt lgkmcnt(0)
    s_barrier
    ds_read_b32 v30, v63 offset:32928
    ds_read_b64 v[96:97], v57 offset:0
    ds_read_b64 v[98:99], v57 offset:8192
    ds_read_b64 v[100:101], v57 offset:16384
    ds_read_b64 v[102:103], v57 offset:24576
    ds_read_b32 v28, v60 offset:32896
    ds_read_b32 v29, v63 offset:32912
    s_waitcnt lgkmcnt(4)
    v_cmp_ne_u32 vcc, 0, v30
    v_pk_add_f32 v[96:97], v[96:97], v[98:99]
    s_waitcnt lgkmcnt(2)
    v_pk_add_f32 v[100:101], v[100:101], v[102:103]
    v_pk_add_f32 v[96:97], v[96:97], v[100:101]
    s_waitcnt lgkmcnt(0)
    v_mul_f32 v52, v96, v28
    v_mul_f32 v53, v97, v28
    v_readfirstlane_b32 s42, v29
    s_cbranch_vccz L_far
    buffer_store_dwordx4 v[52:55], v58, s[56:59], s62 offen
L_pubd:
    s_cmp_lt_u32 s37, 24
    s_cbranch_scc1 L_end
    s_cmp_lg_u32 s42, 0
    s_cbranch_scc1 L_slow
L_poll:
    s_mov_b64 exec, s[26:27]
    s_cbranch_execz L_sk0
    buffer_load_dwordx4 v[64:67], v61, s[56:59], s68 offen sc1
L_sk0:
    s_mov_b64 exec, s[28:29]
    s_cbranch_execz L_sk1
    buffer_load_dwordx4 v[68:71], v61, s[56:59], s69 offen sc1
L_sk1:
    s_mov_b64 exec, s[30:31]
    s_cbranch_execz L_sk2
    buffer_load_dwordx4 v[72:75], v61, s[56:59], s70 offen sc1
L_sk2:
    s_mov_b64 exec, s[34:35]
    s_cbranch_execz L_sk3
    buffer_load_dwordx4 v[76:79], v61, s[56:59], s71 offen sc1
L_sk3:
    s_mov_b64 exec, -1
    s_add_u32 s33, s33, 1
    s_waitcnt vmcnt(0)
    v_cmp_ne_u64 s[26:27], s[24:25], v[66:67]
    v_cmp_ne_u64 s[28:29], s[24:25], v[70:71]
    v_cmp_ne_u64 s[30:31], s[24:25], v[74:75]
    v_cmp_ne_u64 s[34:35], s[24:25], v[78:79]
    v_pk_add_f32 v[18:19], v[64:65], v[68:69]
    v_pk_add_f32 v[20:21], v[72:73], v[76:77]
    v_pk_add_f32 v[18:19], v[18:19], v[48:49]
    s_cmp_ge_u32 s33, 0x400000
    v_pk_add_f32 v[18:19], v[18:19], v[20:21]
    s_cbranch_scc1 L_got
    s_or_b64 s[60:61], s[26:27], s[28:29]
    s_or_b64 s[60:61], s[60:61], s[30:31]
    s_or_b64 s[60:61], s[60:61], s[34:35]
    s_cbranch_scc1 L_poll
L_got:
    s_nop 0
    v_permlane32_swap_b32 v18, v19
    v_add_f32 v18, v18, v19
    v_mov_b32 v19, v18
    s_nop 1
    v_permlane16_swap_b32 v18, v19
    v_add_f32 v18, v18, v19
    s_nop 1
    v_add_f32_dpp v18, v18, v18 row_ror:8 row_mask:0xf bank_mask:0xf
    v_mov_b32 v19, v18
    s_nop 1
    v_permlane32_swap_b32 v18, v19
    v_cvt_pk_bf16_f32 v18, v18, v19
    s_mov_b64 exec, 0xff
    buffer_store_dword v18, v62, s[72:75], s63 offen
L_end:
    s_endpgm
L_far:
    buffer_store_dwordx4 v[52:55], v58, s[56:59], s62 offen sc1
    s_branch L_pubd
L_slow:
    v_and_b32 v22, 63, v0
    v_lshrrev_b32 v23, 3, v22
    s_and_b32 s43, s64, 7
    s_lshl_b32 s43, s43, 5
    v_lshl_add_u32 v24, v23, 11, v62
    v_add_u32 v24, s43, v24
    v_add_u32 v25, 0x4000, v24
    v_add_u32 v26, 8, v23
    s_lshr_b32 s39, s45, 4
    s_lshl_b32 s43, s38, 2
    s_sub_u32 s10, s10, s43
    s_subb_u32 s11, s11, 0
L_slow_loop:
    s_cmp_lt_u32 s39, 0x1000
    s_cbranch_scc0 L_slow_end
    s_lshl_b32 s43, s39, 2
    s_load_dword s40, s[10:11], s43
    s_lshl_b32 s41, s39, 4
    s_sub_i32 s41, s45, s41
    s_waitcnt lgkmcnt(0)
    s_lshl_b32 s40, s40, 15
    buffer_load_dword v27, v24, s[52:55], s40 offen
    buffer_load_dword v28, v25, s[52:55], s40 offen
    v_cmp_le_i32 vcc, s41, v23
    v_cmp_le_i32 s[76:77], s41, v26
    s_waitcnt vmcnt(0)
    v_cndmask_b32 v27, 0, v27, vcc
    v_cndmask_b32 v28, 0, v28, s[76:77]
    v_lshlrev_b32 v29, 16, v27
    v_and_b32 v27, 0xffff0000, v27
    v_add_f32 v48, v48, v29
    v_add_f32 v49, v49, v27
    v_lshlrev_b32 v29, 16, v28
    v_and_b32 v28, 0xffff0000, v28
    v_add_f32 v48, v48, v29
    v_add_f32 v49, v49, v28
    s_add_u32 s39, s39, 1
    s_branch L_slow_loop
L_slow_end:
    v_mul_f32 v48, s42, v48
    v_mul_f32 v49, s42, v49
    s_branch L_poll
.p2align 6
L_helper:
    s_lshl_b32 s44, s37, 2
    v_lshl_add_u32 v20, v30, 7, s44
    v_add_u32 v21, 0x2000, v20
    s_lshl_b32 s42, s36, 5
    s_add_u32 s42, s42, s37
    s_lshl_b32 s42, s42, 12
    v_lshlrev_b32 v12, 6, v30
    s_and_b32 s44, s37, 7
    s_lshl3_add_u32 s44, s36, s44
    s_lshl_b32 s44, s44, 7
    v_add_u32 v13, s44, v12
    v_mov_b32 v16, 0
    s_waitcnt lgkmcnt(0)
    global_load_dword v22, v20, s[10:11]
    global_load_dword v23, v21, s[10:11]
    s_load_dword s45, s[12:13], 0
    s_mov_b32 s56, s18
    s_mov_b32 s57, s19
    s_mov_b32 s58, 0x20080000
    s_mov_b32 s59, 0x20000
    buffer_load_dword v64, v12, s[56:59], s42 offen sc1
    s_mov_b64 exec, 3
    global_load_dword v65, v13, s[14:15] sc1
    s_mov_b64 exec, -1
    v_add_u32 v25, 64, v30
    v_mov_b32 v24, v30
    v_bfrev_b32 v28, 1
    v_lshlrev_b32 v29, 2, v30
    v_mov_b32 v18, 1
    ds_write_b32 v29, v28 offset:33536
    ds_write_b32 v29, v16 offset:33792
    s_waitcnt lgkmcnt(0)
    s_max_i32 s45, s45, 0
    s_min_i32 s45, s45, 0x10000
    s_add_u32 s46, s45, 15
    s_lshr_b32 s46, s46, 4
    s_add_u32 s46, s46, 31
    s_sub_u32 s46, s46, s37
    s_lshr_b32 s46, s46, 5
    s_sub_i32 s48, s46, 1
    v_cmp_gt_i32 s[26:27], s48, v24
    v_cmp_gt_i32 s[28:29], s48, v25
    v_cmp_gt_i32 s[30:31], s46, v24
    v_cmp_gt_i32 s[34:35], s46, v25
    s_andn2_b32 s26, s26, 0xff
    s_waitcnt vmcnt(2)
    v_lshrrev_b32 v26, 6, v22
    v_min_u32 v26, 63, v26
    v_lshlrev_b32 v26, 2, v26
    s_mov_b64 exec, s[26:27]
    ds_add_rtn_u32 v20, v26, v18 offset:33792
    s_mov_b64 exec, -1
    v_lshrrev_b32 v27, 6, v23
    v_min_u32 v27, 63, v27
    v_lshlrev_b32 v27, 2, v27
    s_mov_b64 exec, s[28:29]
    ds_add_rtn_u32 v21, v27, v18 offset:33792
    s_mov_b64 exec, -1
    ds_read_b32 v19, v29 offset:33792
    v_lshlrev_b32 v22, 15, v22
    v_cndmask_b32 v22, v28, v22, s[30:31]
    v_lshlrev_b32 v23, 15, v23
    v_cndmask_b32 v23, v28, v23, s[34:35]
    s_waitcnt lgkmcnt(0)
    v_sub_u32 v14, 8, v19
    s_nop 0
    v_add_u32_dpp v19, v19, v19 row_shr:1 row_mask:0xf bank_mask:0xf bound_ctrl:0
    s_nop 1
    v_add_u32_dpp v19, v19, v19 row_shr:2 row_mask:0xf bank_mask:0xf bound_ctrl:0
    s_nop 1
    v_add_u32_dpp v19, v19, v19 row_shr:4 row_mask:0xf bank_mask:0xf bound_ctrl:0
    s_nop 1
    v_add_u32_dpp v19, v19, v19 row_shr:8 row_mask:0xf bank_mask:0xf bound_ctrl:0
    s_nop 1
    v_add_u32_dpp v19, v19, v19 row_bcast:15 row_mask:0xa bank_mask:0xf
    s_nop 1
    v_add_u32_dpp v19, v19, v19 row_bcast:31 row_mask:0xc bank_mask:0xf
    v_add_u32 v19, v19, v14
    ds_write_b32 v29, v19 offset:33792
    ds_read_b32 v14, v26 offset:33792
    ds_read_b32 v15, v27 offset:33792
    s_waitcnt lgkmcnt(0)
    v_add_u32 v14, v14, v20
    v_add_u32 v15, v15, v21
    v_cndmask_b32 v24, v24, v14, s[26:27]
    v_cndmask_b32 v25, v25, v15, s[28:29]
    v_lshlrev_b32 v24, 2, v24
    v_lshlrev_b32 v25, 2, v25
    ds_write_b32 v24, v22 offset:33024
    ds_write_b32 v25, v23 offset:33024
    s_waitcnt lgkmcnt(0)
    s_barrier
    s_lshl_b32 s22, s36, 7
    s_add_u32 s22, s22, 0x108000
    s_add_u32 s22, s18, s22
    s_addc_u32 s23, s19, 0
    s_load_dwordx2 s[20:21], s[22:23], 0
    v_lshlrev_b32 v7, 4, v30
    v_and_b32 v14, 3, v30
    v_lshlrev_b32 v6, 5, v14
    v_lshlrev_b32 v4, 2, v14
    v_lshrrev_b32 v15, 2, v30
    v_lshlrev_b32 v14, 4, v14
    v_lshl_add_u32 v2, v15, 7, v14
    v_and_b32 v44, 31, v30
    v_lshlrev_b32 v44, 7, v44
    s_lshl_b32 s44, s37, 7
    s_lshl_b32 s39, s36, 12
    s_add_u32 s39, s39, 0x100000
    s_add_u32 s40, s39, s44
    s_getreg_b32 s47, hwreg(HW_REG_XCC_ID)
    s_waitcnt lgkmcnt(0)
    s_add_u32 s24, s20, 0x7f4a7c15
    s_addc_u32 s25, s21, 0x9e3779b9
    v_mov_b32 v42, s24
    v_mov_b32 v43, s25
    s_barrier
    ds_read_b128 v[20:23], v6 offset:32768
    ds_read_b128 v[24:27], v6 offset:32784
    s_waitcnt lgkmcnt(0)
    v_max3_f32 v12, v20, v22, v24
    v_max_f32 v40, v12, v26
    v_sub_f32 v20, v20, v40
    v_sub_f32 v22, v22, v40
    v_sub_f32 v24, v24, v40
    v_sub_f32 v26, v26, v40
    v_exp_f32 v20, v20
    v_exp_f32 v22, v22
    v_exp_f32 v24, v24
    v_exp_f32 v26, v26
    v_mul_f32 v41, v20, v21
    v_fmac_f32 v41, v22, v23
    v_fmac_f32 v41, v24, v25
    v_fmac_f32 v41, v26, v27
    s_mov_b64 exec, 0xf0
    v_mov_b32 v41, s47
    s_mov_b64 exec, 0xff
    buffer_store_dwordx4 v[40:43], v7, s[56:59], s40 offen sc1
    s_mov_b64 exec, -1
    s_mov_b32 s33, 0
L_pml:
    s_sleep 64
    buffer_load_dwordx4 v[32:35], v2, s[56:59], s39 offen sc1
    buffer_load_dwordx4 v[36:39], v2, s[56:59], s39 offen offset:2048 sc1
    buffer_load_dwordx4 v[48:51], v44, s[56:59], s39 offen offset:64 sc1
    s_add_u32 s33, s33, 1
    s_waitcnt vmcnt(0)
    v_cmp_ne_u64 s[26:27], s[24:25], v[34:35]
    v_cmp_ne_u64 s[28:29], s[24:25], v[38:39]
    v_cmp_ne_u64 s[30:31], s[24:25], v[50:51]
    s_cmp_ge_u32 s33, 0x80000
    s_cbranch_scc1 L_gotml
    s_or_b64 s[26:27], s[26:27], s[28:29]
    s_or_b64 s[26:27], s[26:27], s[30:31]
    s_cbranch_scc1 L_pml
L_gotml:
    v_cmp_ne_u32 vcc, s47, v49
    s_cmp_eq_u64 vcc, 0
    s_cselect_b32 s48, 1, 0
    v_mov_b32 v50, s48
    s_sub_u32 s44, 0x10000, s45
    s_cmp_eq_u32 s44, 0
    s_mov_b32 s42, 0xceabae43
    s_cmov_b32 s42, 0xff800000
    v_max3_f32 v12, v32, v36, s42
    s_nop 1
    v_max_f32_dpp v12, v12, v12 row_ror:4 row_mask:0xf bank_mask:0xf
    s_nop 1
    v_max_f32_dpp v12, v12, v12 row_ror:8 row_mask:0xf bank_mask:0xf
    v_mov_b32 v13, v12
    s_nop 1
    v_permlane16_swap_b32 v12, v13
    v_max_f32 v12, v12, v13
    v_mov_b32 v13, v12
    s_nop 1
    v_permlane32_swap_b32 v12, v13
    v_max_f32 v12, v12, v13
    v_sub_f32 v14, v32, v12
    v_sub_f32 v15, v36, v12
    v_sub_f32 v18, s42, v12
    v_sub_f32 v19, v40, v12
    v_exp_f32 v14, v14
    v_exp_f32 v15, v15
    v_exp_f32 v18, v18
    v_exp_f32 v19, v19
    v_cvt_f32_u32 v20, s44
    v_mul_f32 v14, v14, v33
    v_fmac_f32 v14, v15, v37
    s_nop 1
    v_add_f32_dpp v14, v14, v14 row_ror:4 row_mask:0xf bank_mask:0xf
    s_nop 1
    v_add_f32_dpp v14, v14, v14 row_ror:8 row_mask:0xf bank_mask:0xf
    v_mov_b32 v13, v14
    s_nop 1
    v_permlane16_swap_b32 v14, v13
    v_add_f32 v14, v14, v13
    v_mov_b32 v13, v14
    s_nop 1
    v_permlane32_swap_b32 v14, v13
    v_add_f32 v14, v14, v13
    v_fmac_f32 v14, v18, v20
    v_rcp_f32 v14, v14
    s_mov_b64 exec, 0xf
    v_mul_f32 v19, v19, v14
    v_mul_f32 v18, v18, v14
    ds_write_b32 v4, v19 offset:32896
    ds_write_b32 v4, v18 offset:32912
    ds_write_b32 v4, v50 offset:32928
    s_cmp_eq_u32 s37, 0
    s_cbranch_scc0 L_noep
    s_mov_b64 exec, 1
    global_store_dwordx2 v16, v[42:43], s[22:23]
L_noep:
    s_waitcnt lgkmcnt(0)
L_code_end:
    s_endpgm
.section .rodata,"a"
.p2align 6
.amdhsa_kernel standalone__paged_block_table_kv_pagedattention__decode_kernel
  .amdhsa_next_free_vgpr 104
  .amdhsa_next_free_sgpr 78
  .amdhsa_accum_offset 104
  .amdhsa_group_segment_fixed_size 0
  .amdhsa_kernarg_size 64
  .amdhsa_user_sgpr_count 2
  .amdhsa_user_sgpr_kernarg_segment_ptr 1
  .amdhsa_system_sgpr_workgroup_id_x 1
.end_amdhsa_kernel
```
